```python
import torch

def _softmax(x, axis=-1):
    return torch.softmax(x, dim=axis)
def _gelu(x):
    return torch.nn.functional.gelu(x, approximate="tanh")
def _silu(x):
    return torch.nn.functional.silu(x)
def _sigmoid(x):
    return torch.sigmoid(x)
def _layernorm(x, axis=-1, eps=1e-5):
    m = x.mean(dim=axis, keepdim=True)
    v = x.var(dim=axis, keepdim=True, unbiased=False)
    return (x - m) / torch.sqrt(v + eps)
def _scatter_add(tgt, idx, src, axis=0):
    return tgt.clone().index_add_(axis, idx, src)
def _segment_sum(src, seg, n):
    out = torch.zeros((n,) + src.shape[1:], dtype=src.dtype)
    return out.index_add_(0, seg, src)
def _pad(x, pw):
    flat = tuple(v for pair in reversed(pw) for v in pair)
    return torch.nn.functional.pad(x, flat)

kernel_name = 'parallel_sum__sliding_block_cached__glu_gated_geglu__decode'

def setup_inputs():

    _w = (lambda a: (lambda t: t.to(torch.bfloat16) if t.is_floating_point() else t)(torch.as_tensor(a)))
    def _A_setup():
        B, Sq, D = 1, 1, 512
        Hq, Hkv, Sk, Dh = 32, 8, 65536, 128
        assert Hq % Hkv == 0, (Hq, Hkv)
        return {
            "x": _w((lambda *s: torch.randn(*s, dtype=torch.bfloat16) * 0.05)(B, Sq, D)),
            "k_cache": _w((lambda *s: torch.randn(*s, dtype=torch.bfloat16) * 1.6)(B, Hkv, Sk, Dh)),
            "v_cache": _w((lambda *s: torch.randn(*s, dtype=torch.bfloat16) * 0.8)(B, Hkv, Sk, Dh)),
            "wq": _w((lambda *s: torch.randn(*s, dtype=torch.bfloat16) * 1.6)(D, Hq * Dh) * (D ** -0.5)),
            "wo": _w((lambda *s: torch.randn(*s, dtype=torch.bfloat16) * 0.8)(Hq * Dh, D) * ((Hq * Dh) ** -0.5)),
        }
    _A_in = _A_setup()

    def _B_setup():
        B, S, Dm, Df = 1, 1, 512, 1792
        return {
            "x": _w((lambda *s: torch.randn(*s, dtype=torch.bfloat16) * 0.05)(B, S, Dm)),
            "w_gate": _w((lambda *s: torch.randn(*s, dtype=torch.bfloat16) * 0.4)(Dm, Df) * (Dm ** -0.5)),
            "w_up": _w((lambda *s: torch.randn(*s, dtype=torch.bfloat16) * 0.4)(Dm, Df) * (Dm ** -0.5)),
            "w_down": _w((lambda *s: torch.randn(*s, dtype=torch.bfloat16) * 0.4)(Df, Dm) * (Df ** -0.5)),
        }
    _B_in = _B_setup()

    return {
        "A_x": _A_in["x"],
        "A_k_cache": _A_in["k_cache"],
        "A_v_cache": _A_in["v_cache"],
        "A_wq": _A_in["wq"],
        "A_wo": _A_in["wo"],
        "B_x": _B_in["x"],
        "B_w_gate": _B_in["w_gate"],
        "B_w_up": _B_in["w_up"],
        "B_w_down": _B_in["w_down"],
    }

def reference(A_x, A_k_cache, A_v_cache, A_wq, A_wo, B_x, B_w_gate, B_w_up, B_w_down):
    def _A_ref(x, k_cache, v_cache, wq, wo):
        B, Sq, D = x.shape
        Hq, Dh = 32, 128
        Hkv, Sk = k_cache.shape[1], k_cache.shape[2]
        W = min(4096, max(256, Sk // 4))
        rep = Hq // Hkv
        q = (lambda x, *d: x.permute(*d))((x @ wq).reshape(B, Sq, Hq, Dh), 0, 2, 1, 3)
        k = (lambda x, n, axis: torch.repeat_interleave(x, n, dim=axis))(k_cache[:, :, Sk - W:, :], rep, axis=1)
        v = (lambda x, n, axis: torch.repeat_interleave(x, n, dim=axis))(v_cache[:, :, Sk - W:, :], rep, axis=1)
        scores = torch.einsum("bhqd,bhkd->bhqk", q, k) * (Dh ** -0.5)
        p = _softmax(scores, axis=-1)
        o = torch.einsum("bhqk,bhkd->bhqd", p, v)
        return (lambda x, *d: x.permute(*d))(o, 0, 2, 1, 3).reshape(B, Sq, Hq * Dh) @ wo

    def _B_ref(x, w_gate, w_up, w_down):
        g = torch.einsum("bsd,df->bsf", x, w_gate)
        u = torch.einsum("bsd,df->bsf", x, w_up)
        h = _gelu(g) * u
        return torch.einsum("bsf,fd->bsd", h, w_down)

    x = A_x
    xn = _layernorm(x, axis=-1)
    return x + _A_ref(xn, A_k_cache, A_v_cache, A_wq, A_wo) + _B_ref(xn, B_w_gate, B_w_up, B_w_down)
```

```asm
; @launch grid=(256,1,1) block=(512,1,1) lds=128064
.amdgcn_target "amdgcn-amd-amdhsa--gfx950"
.text
.globl parallel_sum__sliding_block_cached__glu_gated_geglu__decode_kernel
.p2align 8
.type parallel_sum__sliding_block_cached__glu_gated_geglu__decode_kernel,@function
parallel_sum__sliding_block_cached__glu_gated_geglu__decode_kernel:
    s_cmp_ge_u32 s2, 256
    s_cbranch_scc1 L_end
    s_load_dwordx16 s[16:31], s[0:1], 0
    s_load_dwordx8 s[32:39], s[0:1], 64
    v_lshrrev_b32 v1, 6, v0
    v_and_b32 v2, 63, v0
    s_and_b32 s3, s2, 7
    v_readfirstlane_b32 s5, v1
    s_lshr_b32 s4, s2, 3
    v_lshrrev_b32 v4, 4, v2
    v_and_b32 v5, 15, v2
    v_lshlrev_b32 v3, 4, v2
    v_lshlrev_b32 v43, 1, v4
    v_xor_b32 v43, v43, v5
    v_lshlrev_b32 v6, 4, v43
    s_and_b32 s50, s5, 1
    s_lshl_b32 s50, s50, 7
    s_lshr_b32 s10, s4, 2
    s_and_b32 s54, s4, 3
    s_lshl_b32 s8, s10, 19
    s_lshl_b32 s9, s5, 16
    s_add_u32 s8, s8, s9
    s_lshl_b32 s9, s3, 10
    s_add_u32 s8, s8, s9
    s_lshl_b32 s9, s54, 8
    s_add_u32 s8, s8, s9
    v_xor_b32 v43, s50, v6
    v_lshl_add_u32 v7, v4, 13, v43
    v_add_u32 v7, s8, v7
    v_add_u32 v8, 31744, v7
    s_lshl_b32 s11, s5, 11
    s_mov_b32 m0, s11
    v_mov_b32 v1, 0
    s_lshl_b32 s8, s3, 24
    s_lshl_b32 s9, s4, 15
    s_add_u32 s8, s8, s9
    s_lshl_b32 s9, s5, 12
    s_add_u32 s8, s8, s9
    s_add_u32 s8, s8, 15728640
    v_xor_b32 v44, v4, v5
    v_lshlrev_b32 v44, 4, v44
    v_lshl_add_u32 v45, v4, 8, v44
    v_add_u32 v10, s8, v45
    v_xor_b32 v11, 64, v10
    v_xor_b32 v12, 128, v10
    v_xor_b32 v13, 192, v10
    s_add_u32 s12, s9, 65536
    s_add_u32 s13, s9, 32768
    s_waitcnt lgkmcnt(0)
    global_load_dwordx4 v[48:51], v3, s[16:17]
    global_load_dword v21, v1, s[38:39] sc1
    global_load_lds_dwordx4 v7, s[22:23] offset:0 nt
    global_load_lds_dwordx4 v8, s[22:23] offset:1024 nt
    s_cmp_lt_u32 s2, 16
    s_cbranch_scc0 L_nopf
    s_cmp_eq_u32 s5, 7
    s_cbranch_scc0 L_nopf
    s_getpc_b64 s[8:9]
L_pc:
    v_lshlrev_b32 v1, 7, v2
    v_min_u32 v1, L_end-L_pc, v1
    global_load_dword v46, v1, s[8:9]
L_nopf:
    s_lshl_b32 s8, s3, 24
    s_lshl_b32 s9, s4, 15
    s_add_u32 s8, s8, s9
    s_lshl_b32 s9, s5, 12
    s_add_u32 s8, s8, s9
    s_add_u32 s8, s8, 15728640
    v_lshl_add_u32 v44, v4, 8, v6
    v_add_u32 v14, s8, v44
    v_xor_b32 v15, 128, v14
    s_lshl_b32 s47, s3, 17
    s_add_u32 s47, s47, 1048576
    s_lshl_b32 s53, s3, 3
    s_add_u32 s53, s53, s10
    v_lshl_add_u32 v16, v4, 10, v43
    s_lshl_b32 s8, s53, 16
    s_lshl_b32 s9, s5, 13
    s_add_u32 s8, s8, s9
    s_lshl_b32 s11, s54, 8
    s_add_u32 s8, s8, s11
    v_add_u32 v16, s8, v16
    v_add_u32 v17, 3072, v16
    s_bfe_u32 s51, s5, 0x10001
    s_lshl_b32 s51, s51, 7
    v_xor_b32 v43, s51, v6
    v_lshl_add_u32 v18, v4, 10, v43
    s_lshl_b32 s8, s53, 15
    s_lshl_b32 s9, s5, 12
    s_add_u32 s8, s8, s9
    s_add_u32 s8, s8, s11
    v_add_u32 v18, s8, v18
    v_mul_u32_u24 v9, 3584, v4
    v_add_u32 v9, v9, v43
    s_and_b32 s11, s4, 15
    s_mul_i32 s8, s11, 114688
    s_mul_i32 s9, s5, 14336
    s_add_u32 s8, s8, s9
    s_lshl_b32 s9, s3, 1
    s_lshr_b32 s27, s4, 4
    s_add_u32 s27, s27, s9
    s_lshl_b32 s9, s27, 8
    s_add_u32 s8, s8, s9
    v_add_u32 v9, s8, v9
    s_cmp_lg_u32 s3, 7
    s_cbranch_scc1 L_hasB
    s_mov_b64 s[28:29], s[16:17]
    s_mov_b64 s[30:31], s[16:17]
    s_mov_b64 s[32:33], s[16:17]
    v_mov_b32 v9, v3
    v_mov_b32 v18, v3
L_hasB:
    s_lshl_b32 s8, s5, 11
    s_add_u32 s57, s8, 98304
    s_lshl_b32 s8, s5, 10
    s_add_u32 s6, s8, 114688
    s_add_u32 s48, s8, 16384
    s_add_u32 s49, s8, 24576
    s_mov_b32 m0, s12
    s_nop 0
    global_load_lds_dwordx4 v10, s[18:19] offset:0 nt
    global_load_lds_dwordx4 v11, s[18:19] offset:1024 nt
    s_lshl_b32 s9, s5, 11
    s_add_u32 s8, s9, s47
    v_add_u32 v32, s8, v3
    v_and_b32 v44, 0x1f0, v3
    s_and_b32 s8, s5, 3
    s_lshl_b32 s8, s8, 1
    s_and_b32 s9, s10, 3
    s_lshl_b32 s9, s9, 3
    s_add_u32 s9, s9, s8
    s_lshl_b32 s9, s9, 9
    s_lshr_b32 s8, s4, 4
    s_lshl_b32 s27, s8, 14
    s_add_u32 s27, s27, s47
    s_add_u32 s27, s27, 16384
    s_add_u32 s8, s27, s9
    v_add_u32 v33, s8, v44
    s_lshr_b32 s8, s4, 3
    s_lshl_b32 s9, s8, 9
    s_add_u32 s9, s9, s47
    s_add_u32 s9, s9, 114688
    v_add_u32 v35, s9, v44
    v_lshlrev_b32 v44, 1, v44
    v_lshrrev_b32 v45, 5, v2
    v_lshl_add_u32 v44, v45, 4, v44
    s_lshl_b32 s8, s8, 14
    s_and_b32 s9, s10, 1
    s_lshl_b32 s9, s9, 3
    s_and_b32 s14, s5, 3
    s_lshl_b32 s14, s14, 1
    s_add_u32 s9, s9, s14
    s_lshl_b32 s9, s9, 10
    s_add_u32 s8, s8, s9
    s_add_u32 s8, s8, s47
    s_add_u32 s8, s8, 49152
    v_add_u32 v34, s8, v44
    s_mov_b32 s42, 0x3ff
    s_mov_b32 s45, 0xfffffc00
    s_mov_b32 s52, 0
    s_getreg_b32 s7, hwreg(HW_REG_XCC_ID, 0, 3)
    v_mov_b32 v44, 0
    v_mov_b32 v45, 127488
    ds_write_b32 v45, v44
    v_mov_b32 v44, 0xff800000
    v_lshlrev_b32 v45, 2, v5
    v_add_u32 v45, 126976, v45
    ds_write_b32 v45, v44
    v_bfe_u32 v43, v2, 2, 2
    v_and_b32 v44, 1, v4
    v_lshl_or_b32 v44, v44, 2, v43
    v_lshlrev_b32 v44, 1, v44
    v_bfe_u32 v45, v2, 1, 1
    s_lshl_b32 s8, s5, 1
    v_add_u32 v45, s8, v45
    v_xor_b32 v44, v44, v45
    v_and_b32 v45, 1, v2
    v_lshlrev_b32 v45, 3, v45
    v_lshl_add_u32 v44, v44, 4, v45
    v_lshl_add_u32 v43, v4, 3, v43
    v_lshl_add_u32 v22, v43, 8, v44
    v_add_u32 v23, 98304, v22
    v_lshlrev_b32 v43, 4, v4
    s_lshl_b32 s8, s10, 7
    s_add_u32 s8, s8, 122880
    v_add_u32 v24, s8, v43
    s_lshl_b32 s8, s11, 6
    s_add_u32 s8, s8, 122880
    v_add_u32 v25, s8, v43
    v_add_u32 v27, 127232, v43
    v_and_b32 v44, 3, v2
    v_lshl_add_u32 v26, v44, 6, v43
    v_add_u32 v26, 124928, v26
    v_lshlrev_b32 v41, 5, v44
    v_add_u32 v41, 126976, v41
    s_lshl_b32 s8, s5, 2
    v_add_u32 v40, s8, v41
    v_lshlrev_b32 v121, 2, v44
    v_add_u32 v121, 126976, v121
    s_lshl_b32 s8, s54, 12
    s_lshr_b32 s9, s5, 2
    s_lshl_b32 s9, s9, 11
    s_add_u32 s8, s8, s9
    s_lshl_b32 s9, s10, 8
    s_add_u32 s8, s8, s9
    s_and_b32 s9, s5, 3
    s_lshl_b32 s9, s9, 6
    s_add_u32 s8, s8, s9
    s_add_u32 s8, s8, s47
    v_add_u32 v36, s8, v43
    s_lshl_b32 s9, s5, 11
    s_add_u32 s8, s27, s9
    s_lshl_b32 s9, s11, 4
    s_add_u32 s8, s8, s9
    v_lshlrev_b32 v44, 9, v4
    v_add_u32 v37, s8, v44
    s_lshl_b32 s8, s54, 15
    s_lshl_b32 s9, s5, 12
    s_add_u32 s8, s8, s9
    s_lshl_b32 s9, s53, 4
    s_add_u32 s8, s8, s9
    s_add_u32 s8, s8, 131072
    v_lshlrev_b32 v44, 10, v4
    v_add_u32 v39, s8, v44
    v_lshlrev_b32 v44, 14, v5
    v_lshrrev_b32 v45, 1, v4
    v_lshl_add_u32 v44, v45, 10, v44
    v_and_b32 v45, 1, v4
    v_lshl_add_u32 v44, v45, 4, v44
    s_lshl_b32 s9, s4, 5
    s_add_u32 s8, s9, s47
    s_lshl_b32 s9, s5, 11
    s_add_u32 s8, s8, s9
    s_add_u32 s8, s8, 49152
    v_add_u32 v38, s8, v44
    v_and_b32 v44, 3, v2
    v_lshlrev_b32 v44, 9, v44
    s_lshl_b32 s9, s4, 4
    s_add_u32 s8, s9, s47
    s_add_u32 s8, s8, 114688
    v_add_u32 v122, s8, v44
    v_lshlrev_b32 v44, 6, v5
    v_lshl_add_u32 v44, v4, 3, v44
    s_lshr_b32 s9, s5, 1
    s_lshl_b32 s9, s9, 8
    s_and_b32 s8, s5, 1
    s_lshl_b32 s8, s8, 5
    s_add_u32 s9, s9, s8
    s_add_u32 s9, s9, 125952
    v_add_u32 v42, s9, v44
    v_and_b32 v44, 1, v4
    v_lshrrev_b32 v45, 1, v4
    v_lshl_add_u32 v44, v44, 1, v45
    v_mov_b32 v132, v44
    v_and_b32 v45, 7, v5
    v_lshl_add_u32 v44, v45, 2, v44
    v_lshlrev_b32 v44, 1, v44
    v_lshrrev_b32 v45, 3, v5
    v_lshl_add_u32 v44, v45, 8, v44
    s_and_b32 s8, s5, 1
    s_lshl_b32 s8, s8, 9
    s_lshr_b32 s9, s5, 1
    s_lshl_b32 s9, s9, 6
    s_add_u32 s8, s8, s9
    s_add_u32 s8, s8, 124928
    v_add_u32 v123, s8, v44
    v_xor_b32 v44, v4, v5
    v_lshlrev_b32 v44, 4, v44
    v_lshl_add_u32 v44, v5, 8, v44
    v_add_u32 v28, s12, v44
    v_xor_b32 v29, 64, v28
    v_xor_b32 v30, 128, v28
    v_xor_b32 v31, 192, v28
    s_cmp_ge_u32 s5, 4
    s_cbranch_scc1 L_noln
    s_waitcnt vmcnt(5)
    s_mov_b32 s8, 0x3f803f80
    v_dot2_f32_bf16 v80, v48, s8, 0
    v_dot2_f32_bf16 v81, v48, v48, 0
    v_dot2_f32_bf16 v80, v49, s8, v80
    v_dot2_f32_bf16 v81, v49, v49, v81
    v_dot2_f32_bf16 v80, v50, s8, v80
    v_dot2_f32_bf16 v81, v50, v50, v81
    v_dot2_f32_bf16 v80, v51, s8, v80
    v_dot2_f32_bf16 v81, v51, v51, v81
    v_add_u32 v43, 123904, v3
    ds_write_b128 v43, v[48:51]
    v_lshlrev_b32 v72, 16, v48
    v_add_f32_dpp v80, v80, v80 row_shr:1 row_mask:0xf bank_mask:0xf bound_ctrl:0
    v_add_f32_dpp v81, v81, v81 row_shr:1 row_mask:0xf bank_mask:0xf bound_ctrl:0
    v_and_b32 v73, 0xffff0000, v48
    v_add_f32_dpp v80, v80, v80 row_shr:2 row_mask:0xf bank_mask:0xf bound_ctrl:0
    v_add_f32_dpp v81, v81, v81 row_shr:2 row_mask:0xf bank_mask:0xf bound_ctrl:0
    v_lshlrev_b32 v74, 16, v49
    v_add_f32_dpp v80, v80, v80 row_shr:4 row_mask:0xf bank_mask:0xf bound_ctrl:0
    v_add_f32_dpp v81, v81, v81 row_shr:4 row_mask:0xf bank_mask:0xf bound_ctrl:0
    v_and_b32 v75, 0xffff0000, v49
    v_add_f32_dpp v80, v80, v80 row_shr:8 row_mask:0xf bank_mask:0xf bound_ctrl:0
    v_add_f32_dpp v81, v81, v81 row_shr:8 row_mask:0xf bank_mask:0xf bound_ctrl:0
    v_lshlrev_b32 v76, 16, v50
    v_add_f32_dpp v80, v80, v80 row_bcast:15 row_mask:0xa bank_mask:0xf
    v_add_f32_dpp v81, v81, v81 row_bcast:15 row_mask:0xa bank_mask:0xf
    v_and_b32 v77, 0xffff0000, v50
    v_add_f32_dpp v80, v80, v80 row_bcast:31 row_mask:0xc bank_mask:0xf
    v_add_f32_dpp v81, v81, v81 row_bcast:31 row_mask:0xc bank_mask:0xf
    v_lshlrev_b32 v78, 16, v51
    v_and_b32 v79, 0xffff0000, v51
    v_readlane_b32 s14, v80, 63
    v_readlane_b32 s15, v81, 63
    v_mov_b32 v82, 0x3b000000
    v_add_u32 v43, 122880, v3
    v_mul_f32 v83, s15, v82
    v_mul_f32 v82, s14, v82
    v_fma_f32 v83, -v82, v82, v83
    v_max_f32 v83, 0, v83
    v_cvt_pk_bf16_f32 v82, v82, v83
    v_and_b32 v83, 0xffff0000, v82
    v_lshlrev_b32 v82, 16, v82
    v_add_f32 v83, 0x3727c5ac, v83
    v_cvt_pk_bf16_f32 v83, v83, v83
    v_and_b32 v83, 0xffff0000, v83
    v_sqrt_f32 v83, v83
    v_sub_f32 v72, v72, v82
    v_sub_f32 v73, v73, v82
    v_sub_f32 v74, v74, v82
    v_sub_f32 v75, v75, v82
    v_sub_f32 v76, v76, v82
    v_sub_f32 v77, v77, v82
    v_sub_f32 v78, v78, v82
    v_sub_f32 v79, v79, v82
    v_cvt_pk_bf16_f32 v83, v83, v83
    v_and_b32 v83, 0xffff0000, v83
    v_rcp_f32 v83, v83
    v_cvt_pk_bf16_f32 v84, v72, v73
    v_cvt_pk_bf16_f32 v85, v74, v75
    v_cvt_pk_bf16_f32 v86, v76, v77
    v_cvt_pk_bf16_f32 v87, v78, v79
    v_lshlrev_b32 v72, 16, v84
    v_and_b32 v73, 0xffff0000, v84
    v_lshlrev_b32 v74, 16, v85
    v_and_b32 v75, 0xffff0000, v85
    v_lshlrev_b32 v76, 16, v86
    v_and_b32 v77, 0xffff0000, v86
    v_lshlrev_b32 v78, 16, v87
    v_and_b32 v79, 0xffff0000, v87
    v_mul_f32 v72, v72, v83
    v_mul_f32 v73, v73, v83
    v_mul_f32 v74, v74, v83
    v_mul_f32 v75, v75, v83
    v_mul_f32 v76, v76, v83
    v_mul_f32 v77, v77, v83
    v_mul_f32 v78, v78, v83
    v_mul_f32 v79, v79, v83
    v_cvt_pk_bf16_f32 v84, v72, v73
    v_cvt_pk_bf16_f32 v85, v74, v75
    v_cvt_pk_bf16_f32 v86, v76, v77
    v_cvt_pk_bf16_f32 v87, v78, v79
    ds_write_b128 v43, v[84:87]
L_noln:
    s_waitcnt vmcnt(2) lgkmcnt(0)
    v_readfirstlane_b32 s40, v21
    s_barrier
    ds_read_b64_tr_b16 v[72:73], v22 offset:0
    ds_read_b64_tr_b16 v[74:75], v22 offset:1024
    ds_read_b128 v[80:83], v24 offset:0
    ds_read_b64_tr_b16 v[76:77], v22 offset:8192
    ds_read_b64_tr_b16 v[78:79], v22 offset:9216
    ds_read_b128 v[84:87], v24 offset:64
    s_add_u32 s40, s40, 1
    s_and_b32 s41, s40, 0x3ff
    v_mov_b32 v19, s41
    s_lshl_b32 s8, s7, 7
    s_xor_b32 s8, s8, s41
    v_mov_b32 v20, s8
    s_lshl_b32 s46, s3, 14
    s_add_u32 s46, s46, 262144
    s_sub_u32 s46, s46, s47
    s_lshl_b32 s8, s5, 6
    s_add_u32 s8, s8, 127552
    v_lshl_add_u32 v44, v4, 4, s8
    s_waitcnt lgkmcnt(3)
    v_mfma_f32_16x16x32_bf16 v[88:91], v[72:75], v[80:83], 0
    s_waitcnt lgkmcnt(0)
    v_mfma_f32_16x16x32_bf16 v[88:91], v[76:79], v[84:87], v[88:91]
    s_mov_b32 exec_lo, 0x00010001
    s_mov_b32 exec_hi, 0x00010001
    s_nop 5
    v_add_u32 v88, 0x200, v88
    v_add_u32 v89, 0x200, v89
    v_add_u32 v90, 0x200, v90
    v_add_u32 v91, 0x200, v91
    v_and_or_b32 v88, v88, s45, v19
    v_and_or_b32 v89, v89, s45, v19
    v_and_or_b32 v90, v90, s45, v19
    v_and_or_b32 v91, v91, s45, v20
    global_store_dwordx4 v36, v[88:91], s[38:39]
    ds_write_b128 v44, v[88:91]
    s_mov_b64 exec, -1
    s_barrier
    global_load_lds_dwordx4 v12, s[18:19] offset:2048 nt
    global_load_lds_dwordx4 v13, s[18:19] offset:3072 nt
    s_mov_b32 m0, s13
    s_nop 0
    global_load_lds_dwordx4 v14, s[20:21] offset:0 nt
    s_waitcnt vmcnt(2)
    global_load_dwordx4 v[52:55], v32, s[38:39] sc1
    global_load_dwordx4 v[56:59], v32, s[38:39] offset:1024 sc1
    s_waitcnt lgkmcnt(0)
    s_barrier
    global_load_lds_dwordx4 v14, s[20:21] offset:1024 nt
    global_load_lds_dwordx4 v15, s[20:21] offset:2048 nt
    global_load_lds_dwordx4 v15, s[20:21] offset:3072 nt
    s_waitcnt vmcnt(3)
L_pollq:
    v_bitop3_b32 v44, v52, v53, s41 bitop3:0x7e
    v_bitop3_b32 v1, v56, v57, s41 bitop3:0x7e
    v_xor_b32 v43, s41, v55
    v_xor_b32 v45, s41, v59
    v_or_b32 v44, v44, v1
    v_bitop3_b32 v1, v54, v58, s41 bitop3:0x7e
    v_bitop3_b32 v44, v44, v1, s42 bitop3:0xa8
    v_or_b32 v1, v43, v45
    v_and_b32 v1, 0x7f, v1
    v_or_b32 v44, v44, v1
    v_cmp_ne_u32 vcc, 0, v44
    s_cbranch_vccz L_pollq_ok
    s_add_u32 s52, s52, 1
    s_cmp_gt_u32 s52, 100000
    s_cbranch_scc1 L_pollq_ok
    s_and_b32 s8, s52, 7
    s_cmp_lg_u32 s8, 3
    s_cbranch_scc1 L_noqb1
    v_and_b32 v1, 0x1f0, v3
    v_add_u32 v1, 127552, v1
    ds_read_b128 v[64:67], v1
    s_lshl_b32 s8, s3, 14
    s_lshl_b32 s9, s54, 12
    s_add_u32 s8, s8, s9
    s_lshr_b32 s9, s4, 2
    s_lshl_b32 s9, s9, 8
    s_add_u32 s8, s8, s9
    s_add_u32 s8, s8, 262144
    v_bfe_u32 v1, v2, 4, 1
    v_lshlrev_b32 v1, 11, v1
    v_lshl_add_u32 v1, v5, 4, v1
    v_add_u32 v1, s8, v1
    s_waitcnt lgkmcnt(0)
    s_mov_b32 exec_hi, 0
    global_store_dwordx4 v1, v[64:67], s[38:39] sc1
    s_mov_b64 exec, -1
L_noqb1:
    s_and_b32 s8, s52, 7
    s_cmp_eq_u32 s8, 7
    s_cselect_b32 s8, s46, 0
    v_add_u32 v1, s8, v32
    global_load_dwordx4 v[52:55], v1, s[38:39] sc1
    global_load_dwordx4 v[56:59], v1, s[38:39] offset:1024 sc1
    s_waitcnt vmcnt(0)
    s_branch L_pollq
L_pollq_ok:
    s_mov_b32 m0, s48
    s_nop 0
    global_load_lds_dwordx4 v9, s[28:29] offset:0 nt
    v_and_b32 v43, s42, v43
    v_and_b32 v45, s42, v45
    s_lshl_b32 s8, s7, 7
    v_cmp_ne_u32 vcc, s8, v43
    v_cmp_ne_u32 s[10:11], s8, v45
    v_and_b32 v52, s45, v52
    v_and_b32 v56, s45, v56
    v_and_b32 v53, s45, v53
    v_and_b32 v57, s45, v57
    v_and_b32 v54, s45, v54
    v_and_b32 v58, s45, v58
    v_and_b32 v55, s45, v55
    v_and_b32 v59, s45, v59
    s_or_b64 vcc, vcc, s[10:11]
    s_cbranch_vccz L_isloc
    v_mov_b32 v44, 127488
    v_mov_b32 v43, 1
    ds_write_b32 v44, v43
L_isloc:
    v_add_f32 v52, v52, v56
    v_add_f32 v53, v53, v57
    v_add_f32 v54, v54, v58
    v_add_f32 v55, v55, v59
    s_nop 0
    v_permlane32_swap_b32 v52, v53
    v_permlane32_swap_b32 v54, v55
    v_add_f32 v52, v52, v53
    v_add_f32 v54, v54, v55
    s_nop 1
    v_permlane16_swap_b32 v52, v54
    v_add_f32 v52, v52, v54
    v_cvt_pk_bf16_f32 v52, v52, v52
    ds_write_b16 v123, v52
    s_mov_b32 m0, s49
    s_nop 0
    global_load_lds_dwordx4 v9, s[30:31] offset:0 nt
    s_waitcnt lgkmcnt(0)
    s_barrier
    ds_read_b128 v[88:91], v26 offset:0
    ds_read_b128 v[92:95], v26 offset:256
    ds_read_b128 v[96:99], v26 offset:512
    ds_read_b128 v[100:103], v26 offset:768
    v_mov_b32 v44, 127488
    ds_read_b32 v45, v44
    s_mov_b32 m0, s57
    s_nop 0
    global_load_lds_dwordx4 v16, s[24:25] offset:0 nt
    ds_read_b128 v[72:75], v28
    ds_read_b128 v[76:79], v29
    ds_read_b128 v[80:83], v30
    ds_read_b128 v[84:87], v31
    s_waitcnt lgkmcnt(3)
    v_mfma_f32_16x16x32_bf16 v[104:107], v[72:75], v[88:91], 0
    s_waitcnt lgkmcnt(2)
    v_mfma_f32_16x16x32_bf16 v[104:107], v[76:79], v[92:95], v[104:107]
    s_waitcnt lgkmcnt(1)
    v_mfma_f32_16x16x32_bf16 v[104:107], v[80:83], v[96:99], v[104:107]
    s_waitcnt lgkmcnt(0)
    v_mfma_f32_16x16x32_bf16 v[104:107], v[84:87], v[100:103], v[104:107]
    s_waitcnt lgkmcnt(0)
    v_readfirstlane_b32 s26, v45
    s_nop 0
    s_cmp_eq_u32 s26, 0
    s_cbranch_scc1 L_noqb2
    s_cmp_lg_u32 s5, 0
    s_cbranch_scc1 L_noqb2
    v_and_b32 v1, 0x1f0, v3
    v_add_u32 v1, 127552, v1
    ds_read_b128 v[64:67], v1
    s_lshl_b32 s8, s3, 14
    s_lshl_b32 s9, s54, 12
    s_add_u32 s8, s8, s9
    s_lshr_b32 s9, s4, 2
    s_lshl_b32 s9, s9, 8
    s_add_u32 s8, s8, s9
    s_add_u32 s8, s8, 262144
    v_bfe_u32 v1, v2, 4, 1
    v_lshlrev_b32 v1, 11, v1
    v_lshl_add_u32 v1, v5, 4, v1
    v_add_u32 v1, s8, v1
    s_waitcnt lgkmcnt(0)
    s_mov_b32 exec_hi, 0
    global_store_dwordx4 v1, v[64:67], s[38:39] sc1
    s_mov_b64 exec, -1
L_noqb2:
    s_nop 5
    v_cvt_pk_bf16_f32 v72, v104, v105
    v_cvt_pk_bf16_f32 v73, v106, v107
    v_lshlrev_b32 v104, 16, v72
    v_and_b32 v105, 0xffff0000, v72
    v_lshlrev_b32 v106, 16, v73
    v_and_b32 v107, 0xffff0000, v73
    v_mul_f32 v104, 0x3db504f3, v104
    v_mul_f32 v105, 0x3db504f3, v105
    v_mul_f32 v106, 0x3db504f3, v106
    v_mul_f32 v107, 0x3db504f3, v107
    v_cvt_pk_bf16_f32 v72, v104, v105
    v_cvt_pk_bf16_f32 v73, v106, v107
    v_lshlrev_b32 v104, 16, v72
    v_and_b32 v105, 0xffff0000, v72
    v_lshlrev_b32 v106, 16, v73
    v_and_b32 v107, 0xffff0000, v73
    v_max3_f32 v76, v104, v105, v106
    v_max_f32 v76, v76, v107
    s_mov_b32 exec_lo, 0x000f000f
    s_mov_b32 exec_hi, 0x000f000f
    ds_max_f32 v121, v76
    s_mov_b64 exec, -1
    global_load_lds_dwordx4 v17, s[24:25] offset:1024 nt
    s_waitcnt lgkmcnt(0)
    s_barrier
    ds_read_b32 v76, v121
    s_mov_b32 s8, 0x3fb8aa3b
    s_waitcnt lgkmcnt(0)
    v_mul_f32 v76, 0x3fb8aa3b, v76
    v_and_b32 v120, s45, v76
    v_fma_f32 v104, v104, s8, -v120
    v_fma_f32 v105, v105, s8, -v120
    v_fma_f32 v106, v106, s8, -v120
    v_fma_f32 v107, v107, s8, -v120
    v_exp_f32 v104, v104
    v_exp_f32 v105, v105
    v_exp_f32 v106, v106
    v_exp_f32 v107, v107
    s_nop 0
    v_cvt_pk_bf16_f32 v72, v104, v105
    v_cvt_pk_bf16_f32 v73, v106, v107
    s_mov_b32 exec_lo, 0x000f000f
    s_mov_b32 exec_hi, 0x000f000f
    ds_write_b64 v42, v[72:73]
    s_mov_b64 exec, -1
    v_add_f32 v76, v104, v105
    v_add_f32 v78, v106, v107
    s_mov_b32 m0, s6
    s_nop 0
    global_load_lds_dwordx4 v18, s[32:33] offset:0 nt
    s_waitcnt lgkmcnt(0)
    s_barrier
    ds_read_b128 v[96:99], v26 offset:1024
    ds_read_b128 v[100:103], v26 offset:1280
    ds_read_b128 v[104:107], v26 offset:1536
    ds_read_b128 v[108:111], v26 offset:1792
    v_add_f32 v76, v76, v78
    v_mov_b32 v77, v76
    s_nop 1
    v_permlane32_swap_b32 v76, v77
    v_add_f32 v76, v76, v77
    v_mov_b32 v77, v76
    s_nop 1
    v_permlane16_swap_b32 v76, v77
    v_add_f32 v76, v76, v77
    s_mov_b64 exec, 15
    ds_write_b32 v40, v76 offset:128
    s_mov_b64 exec, -1
    s_waitcnt vmcnt(5) lgkmcnt(0)
    s_barrier
    ds_read_b64_tr_b16 v[80:81], v22 offset:32768
    ds_read_b64_tr_b16 v[82:83], v22 offset:33792
    ds_read_b64_tr_b16 v[84:85], v22 offset:40960
    ds_read_b64_tr_b16 v[86:87], v22 offset:41984
    ds_read_b64_tr_b16 v[88:89], v22 offset:49152
    ds_read_b64_tr_b16 v[90:91], v22 offset:50176
    ds_read_b64_tr_b16 v[92:93], v22 offset:57344
    ds_read_b64_tr_b16 v[94:95], v22 offset:58368
    ds_read_b128 v[116:119], v41 offset:128
    ds_read_b128 v[72:75], v41 offset:144
    s_waitcnt lgkmcnt(8)
    v_mfma_f32_16x16x32_bf16 v[112:115], v[80:83], v[96:99], 0
    s_waitcnt lgkmcnt(6)
    v_mfma_f32_16x16x32_bf16 v[112:115], v[84:87], v[100:103], v[112:115]
    s_waitcnt lgkmcnt(4)
    v_mfma_f32_16x16x32_bf16 v[112:115], v[88:91], v[104:107], v[112:115]
    s_waitcnt lgkmcnt(2)
    v_mfma_f32_16x16x32_bf16 v[112:115], v[92:95], v[108:111], v[112:115]
    s_waitcnt lgkmcnt(0)
    v_add_f32 v116, v116, v117
    v_add_f32 v118, v118, v119
    v_add_f32 v72, v72, v73
    v_add_f32 v74, v74, v75
    v_add_f32 v116, v116, v118
    v_add_f32 v72, v72, v74
    v_mov_b32 v76, v120
    v_add_f32 v77, v116, v72
    s_mov_b32 exec_lo, 0x000f000f
    s_mov_b32 exec_hi, 0x000f000f
    v_and_or_b32 v112, v112, s45, v19
    v_and_or_b32 v113, v113, s45, v19
    v_and_or_b32 v114, v114, s45, v19
    v_and_or_b32 v115, v115, s45, v19
    s_cmp_eq_u32 s26, 0
    s_cbranch_scc1 L_st_1_l
    global_store_dwordx4 v38, v[112:115], s[38:39] sc1
    s_branch L_st_1_d
L_st_1_l:
    global_store_dwordx4 v38, v[112:115], s[38:39]
L_st_1_d:
    s_cmp_lg_u32 s5, 7
    s_cbranch_scc1 L_noml
    v_mov_b32 v78, 0
    v_mov_b32 v79, 0
    v_and_or_b32 v76, v76, s45, v19
    v_and_or_b32 v77, v77, s45, v19
    v_and_or_b32 v78, v78, s45, v19
    v_and_or_b32 v79, v79, s45, v19
    s_mov_b64 exec, 15
    s_cmp_eq_u32 s26, 0
    s_cbranch_scc1 L_st_2_l
    global_store_dwordx4 v122, v[76:79], s[38:39] sc1
    s_branch L_st_2_d
L_st_2_l:
    global_store_dwordx4 v122, v[76:79], s[38:39]
L_st_2_d:
L_noml:
    s_mov_b64 exec, -1
    s_waitcnt vmcnt(4)
    s_barrier
    ds_read_b64_tr_b16 v[72:73], v22 offset:16384
    ds_read_b64_tr_b16 v[74:75], v22 offset:17408
    ds_read_b64_tr_b16 v[76:77], v22 offset:24576
    ds_read_b64_tr_b16 v[78:79], v22 offset:25600
    ds_read_b128 v[80:83], v25
    s_waitcnt lgkmcnt(0)
    v_mfma_f32_16x16x32_bf16 v[84:87], v[72:75], v[80:83], 0
    v_mfma_f32_16x16x32_bf16 v[88:91], v[76:79], v[80:83], 0
    s_cmp_eq_u32 s3, 7
    s_cbranch_scc1 L_nogpub
    s_mov_b32 exec_lo, 0x00010001
    s_mov_b32 exec_hi, 0x00010001
    s_nop 3
    v_and_or_b32 v84, v84, s45, v19
    v_and_or_b32 v85, v85, s45, v19
    v_and_or_b32 v86, v86, s45, v19
    v_and_or_b32 v87, v87, s45, v19
    v_and_or_b32 v88, v88, s45, v19
    v_and_or_b32 v89, v89, s45, v19
    v_and_or_b32 v90, v90, s45, v19
    v_and_or_b32 v91, v91, s45, v19
    s_cmp_eq_u32 s26, 0
    s_cbranch_scc1 L_st_3_l
    global_store_dwordx4 v37, v[84:87], s[38:39] sc1
    global_store_dwordx4 v37, v[88:91], s[38:39] offset:256 sc1
    s_branch L_st_3_d
L_st_3_l:
    global_store_dwordx4 v37, v[84:87], s[38:39]
    global_store_dwordx4 v37, v[88:91], s[38:39] offset:256
L_st_3_d:
    s_mov_b64 exec, -1
L_nogpub:
    s_cmp_ge_u32 s5, 4
    s_cbranch_scc1 L_hpath
    global_load_dwordx4 v[64:67], v34, s[38:39] sc1
    global_load_dwordx4 v[60:63], v34, s[38:39] offset:1024 sc1
    global_load_dwordx4 v[68:71], v35, s[38:39] sc1
    s_waitcnt vmcnt(0)
L_pollo:
    v_bitop3_b32 v43, v64, v65, s41 bitop3:0x7e
    v_bitop3_b32 v44, v66, v67, s41 bitop3:0x7e
    v_bitop3_b32 v43, v43, v44, s42 bitop3:0xa8
    v_cmp_ne_u32 vcc, 0, v43
    v_bitop3_b32 v43, v60, v61, s41 bitop3:0x7e
    v_bitop3_b32 v44, v62, v63, s41 bitop3:0x7e
    v_bitop3_b32 v43, v43, v44, s42 bitop3:0xa8
    v_cmp_ne_u32 s[8:9], 0, v43
    v_bitop3_b32 v43, v68, v69, s41 bitop3:0x7e
    v_bitop3_b32 v44, v70, v71, s41 bitop3:0x7e
    v_bitop3_b32 v43, v43, v44, s42 bitop3:0xa8
    v_cmp_ne_u32 s[10:11], 0, v43
    s_nop 0
    s_or_b64 s[14:15], vcc, s[8:9]
    s_or_b64 s[14:15], s[14:15], s[10:11]
    s_cmp_eq_u64 s[14:15], 0
    s_cbranch_scc1 L_pollo_ok
    s_add_u32 s52, s52, 1
    s_cmp_gt_u32 s52, 100000
    s_cbranch_scc1 L_pollo_ok
    s_sleep 1
    s_mov_b64 exec, vcc
    s_cbranch_execz L_pollo_s0
    global_load_dwordx4 v[64:67], v34, s[38:39] sc1
L_pollo_s0:
    s_mov_b64 exec, s[8:9]
    s_cbranch_execz L_pollo_s1
    global_load_dwordx4 v[60:63], v34, s[38:39] offset:1024 sc1
L_pollo_s1:
    s_mov_b64 exec, s[10:11]
    s_cbranch_execz L_pollo_s2
    global_load_dwordx4 v[68:71], v35, s[38:39] sc1
L_pollo_s2:
    s_mov_b64 exec, -1
    s_waitcnt vmcnt(0)
    s_branch L_pollo
L_pollo_ok:
    v_and_b32 v68, s45, v68
    v_and_b32 v69, s45, v69
    v_and_b32 v64, s45, v64
    v_max_f32_dpp v92, v68, v68 row_ror:8 row_mask:0xf bank_mask:0xf
    v_and_b32 v65, s45, v65
    v_and_b32 v66, s45, v66
    v_max_f32_dpp v92, v92, v92 row_ror:4 row_mask:0xf bank_mask:0xf
    v_and_b32 v67, s45, v67
    v_and_b32 v60, s45, v60
    v_max_f32_dpp v92, v92, v92 row_ror:2 row_mask:0xf bank_mask:0xf
    v_and_b32 v61, s45, v61
    v_and_b32 v62, s45, v62
    v_max_f32_dpp v92, v92, v92 row_ror:1 row_mask:0xf bank_mask:0xf
    v_and_b32 v63, s45, v63
    v_mov_b32 v93, v92
    v_and_b32 v43, 1, v4
    v_lshrrev_b32 v44, 1, v4
    v_permlane16_swap_b32 v92, v93
    v_max_f32 v92, v92, v93
    v_sub_f32 v94, v68, v92
    v_exp_f32 v94, v94
    v_lshl_add_u32 v43, v44, 2, v43
    v_mul_f32 v95, v94, v69
    v_mul_f32 v64, v64, v94
    v_mul_f32 v65, v65, v94
    v_mul_f32 v66, v66, v94
    v_mul_f32 v67, v67, v94
    v_mul_f32 v60, v60, v94
    v_mul_f32 v61, v61, v94
    v_mul_f32 v62, v62, v94
    v_mul_f32 v63, v63, v94
    v_mov_b32 v93, v95
    s_lshl_b32 s8, s5, 5
    s_add_u32 s8, s8, 127232
    v_lshl_add_u32 v45, v43, 1, s8
    v_permlane16_swap_b32 v64, v65
    v_permlane16_swap_b32 v66, v67
    v_permlane16_swap_b32 v60, v61
    v_permlane16_swap_b32 v62, v63
    v_permlane16_swap_b32 v95, v93
    v_add_f32 v64, v64, v65
    v_add_f32 v66, v66, v67
    v_add_f32 v60, v60, v61
    v_add_f32 v62, v62, v63
    v_add_f32 v95, v95, v93
    v_add_f32_dpp v64, v64, v64 row_ror:8 row_mask:0xf bank_mask:0xf
    v_add_f32_dpp v66, v66, v66 row_ror:8 row_mask:0xf bank_mask:0xf
    v_add_f32_dpp v60, v60, v60 row_ror:8 row_mask:0xf bank_mask:0xf
    v_add_f32_dpp v62, v62, v62 row_ror:8 row_mask:0xf bank_mask:0xf
    v_add_f32_dpp v95, v95, v95 row_ror:8 row_mask:0xf bank_mask:0xf
    v_add_f32_dpp v64, v64, v64 row_ror:4 row_mask:0xf bank_mask:0xf
    v_add_f32_dpp v66, v66, v66 row_ror:4 row_mask:0xf bank_mask:0xf
    v_add_f32_dpp v60, v60, v60 row_ror:4 row_mask:0xf bank_mask:0xf
    v_add_f32_dpp v62, v62, v62 row_ror:4 row_mask:0xf bank_mask:0xf
    v_add_f32_dpp v95, v95, v95 row_ror:4 row_mask:0xf bank_mask:0xf
    v_add_f32_dpp v64, v64, v64 row_ror:2 row_mask:0xf bank_mask:0xf
    v_add_f32_dpp v66, v66, v66 row_ror:2 row_mask:0xf bank_mask:0xf
    v_add_f32_dpp v60, v60, v60 row_ror:2 row_mask:0xf bank_mask:0xf
    v_add_f32_dpp v62, v62, v62 row_ror:2 row_mask:0xf bank_mask:0xf
    v_add_f32_dpp v95, v95, v95 row_ror:2 row_mask:0xf bank_mask:0xf
    v_add_f32_dpp v64, v64, v64 row_ror:1 row_mask:0xf bank_mask:0xf
    v_add_f32_dpp v66, v66, v66 row_ror:1 row_mask:0xf bank_mask:0xf
    v_add_f32_dpp v60, v60, v60 row_ror:1 row_mask:0xf bank_mask:0xf
    v_add_f32_dpp v62, v62, v62 row_ror:1 row_mask:0xf bank_mask:0xf
    v_add_f32_dpp v95, v95, v95 row_ror:1 row_mask:0xf bank_mask:0xf
    v_rcp_f32 v95, v95
    s_nop 0
    v_mul_f32 v64, v64, v95
    v_mul_f32 v66, v66, v95
    v_mul_f32 v60, v60, v95
    v_mul_f32 v62, v62, v95
    v_cvt_pk_bf16_f32 v64, v64, v64
    v_cvt_pk_bf16_f32 v66, v66, v66
    v_cvt_pk_bf16_f32 v60, v60, v60
    v_cvt_pk_bf16_f32 v62, v62, v62
    s_mov_b32 exec_lo, 0x00010001
    s_mov_b32 exec_hi, 0x00010001
    ds_write_b16 v45, v64
    ds_write_b16 v45, v66 offset:4
    ds_write_b16 v45, v60 offset:16
    ds_write_b16 v45, v62 offset:20
    s_mov_b64 exec, -1
    s_branch L_tjoin
L_hpath:
    s_cmp_eq_u32 s3, 7
    s_cbranch_scc1 L_hzero
    global_load_dwordx4 v[60:63], v33, s[38:39] sc1
    global_load_dwordx4 v[64:67], v33, s[38:39] offset:512 sc1
    s_waitcnt vmcnt(0)
L_pollh:
    v_bitop3_b32 v43, v60, v61, s41 bitop3:0x7e
    v_bitop3_b32 v44, v62, v63, s41 bitop3:0x7e
    v_bitop3_b32 v43, v43, v44, s42 bitop3:0xa8
    v_cmp_ne_u32 vcc, 0, v43
    v_bitop3_b32 v43, v64, v65, s41 bitop3:0x7e
    v_bitop3_b32 v44, v66, v67, s41 bitop3:0x7e
    v_bitop3_b32 v43, v43, v44, s42 bitop3:0xa8
    v_cmp_ne_u32 s[8:9], 0, v43
    s_nop 0
    s_or_b64 s[14:15], vcc, s[8:9]
    s_cmp_eq_u64 s[14:15], 0
    s_cbranch_scc1 L_pollh_ok
    s_add_u32 s52, s52, 1
    s_cmp_gt_u32 s52, 100000
    s_cbranch_scc1 L_pollh_ok
    s_sleep 1
    s_mov_b64 exec, vcc
    s_cbranch_execz L_pollh_s0
    global_load_dwordx4 v[60:63], v33, s[38:39] sc1
L_pollh_s0:
    s_mov_b64 exec, s[8:9]
    s_cbranch_execz L_pollh_s1
    global_load_dwordx4 v[64:67], v33, s[38:39] offset:512 sc1
L_pollh_s1:
    s_mov_b64 exec, -1
    s_waitcnt vmcnt(0)
    s_branch L_pollh
L_pollh_ok:
    s_mov_b32 s10, 0
    s_mov_b32 s11, -1
    v_cndmask_b32 v92, v60, v61, s[10:11]
    v_cndmask_b32 v93, v62, v63, s[10:11]
    v_cndmask_b32 v94, v64, v65, s[10:11]
    v_cndmask_b32 v95, v66, v67, s[10:11]
    v_and_b32 v92, s45, v92
    v_and_b32 v93, s45, v93
    v_and_b32 v94, s45, v94
    v_and_b32 v95, s45, v95
    v_add_f32_dpp v92, v92, v92 row_ror:8 row_mask:0xf bank_mask:0xf
    v_add_f32_dpp v93, v93, v93 row_ror:8 row_mask:0xf bank_mask:0xf
    v_add_f32_dpp v94, v94, v94 row_ror:8 row_mask:0xf bank_mask:0xf
    v_add_f32_dpp v95, v95, v95 row_ror:8 row_mask:0xf bank_mask:0xf
    v_add_f32_dpp v92, v92, v92 row_ror:4 row_mask:0xf bank_mask:0xf
    v_add_f32_dpp v93, v93, v93 row_ror:4 row_mask:0xf bank_mask:0xf
    v_add_f32_dpp v94, v94, v94 row_ror:4 row_mask:0xf bank_mask:0xf
    v_add_f32_dpp v95, v95, v95 row_ror:4 row_mask:0xf bank_mask:0xf
    v_add_f32_dpp v92, v92, v92 row_ror:2 row_mask:0xf bank_mask:0xf
    v_add_f32_dpp v93, v93, v93 row_ror:2 row_mask:0xf bank_mask:0xf
    v_add_f32_dpp v94, v94, v94 row_ror:2 row_mask:0xf bank_mask:0xf
    v_add_f32_dpp v95, v95, v95 row_ror:2 row_mask:0xf bank_mask:0xf
    v_add_f32_dpp v92, v92, v92 row_ror:1 row_mask:0xf bank_mask:0xf
    v_add_f32_dpp v93, v93, v93 row_ror:1 row_mask:0xf bank_mask:0xf
    v_add_f32_dpp v94, v94, v94 row_ror:1 row_mask:0xf bank_mask:0xf
    v_add_f32_dpp v95, v95, v95 row_ror:1 row_mask:0xf bank_mask:0xf
    s_nop 0
    v_permlane16_swap_b32 v92, v93
    v_permlane16_swap_b32 v94, v95
    v_cvt_pk_bf16_f32 v92, v92, v93
    v_cvt_pk_bf16_f32 v94, v94, v95
    v_and_b32 v93, 0xffff0000, v92
    v_lshlrev_b32 v92, 16, v92
    v_and_b32 v95, 0xffff0000, v94
    v_lshlrev_b32 v94, 16, v94
    v_mul_f32 v96, v92, v92
    v_mul_f32 v97, v94, v94
    v_mul_f32 v96, 0x3d372713, v96
    v_mul_f32 v97, 0x3d372713, v97
    v_fma_f32 v96, v96, v92, v92
    v_fma_f32 v97, v97, v94, v94
    v_mul_f32 v96, 0xc0135761, v96
    v_mul_f32 v97, 0xc0135761, v97
    v_exp_f32 v96, v96
    v_exp_f32 v97, v97
    s_nop 0
    v_add_f32 v96, 1.0, v96
    v_add_f32 v97, 1.0, v97
    v_rcp_f32 v96, v96
    v_rcp_f32 v97, v97
    s_nop 0
    v_mul_f32 v96, v96, v92
    v_mul_f32 v97, v97, v94
    v_cvt_pk_bf16_f32 v96, v96, v96
    v_cvt_pk_bf16_f32 v97, v97, v97
    v_and_b32 v96, 0xffff0000, v96
    v_and_b32 v97, 0xffff0000, v97
    v_mul_f32 v96, v96, v93
    v_mul_f32 v97, v97, v95
    v_cvt_pk_bf16_f32 v96, v96, v96
    v_cvt_pk_bf16_f32 v97, v97, v97
    s_branch L_hwr
L_hzero:
    v_mov_b32 v96, 0
    v_mov_b32 v97, 0
L_hwr:
    s_lshl_b32 s8, s5, 4
    s_add_u32 s8, s8, 127296
    v_lshl_add_u32 v43, v132, 1, s8
    s_mov_b32 exec_lo, 0x00010001
    s_mov_b32 exec_hi, 0x00010001
    ds_write_b16 v43, v96
    ds_write_b16 v43, v97 offset:8
    s_mov_b64 exec, -1
L_tjoin:
    s_waitcnt vmcnt(0) lgkmcnt(0)
    s_barrier
    ds_read_b64_tr_b16 v[80:81], v23 offset:16384
    ds_read_b64_tr_b16 v[82:83], v23 offset:17408
    ds_read_b128 v[92:95], v27 offset:128
    ds_read_b64_tr_b16 v[72:73], v23 offset:0
    ds_read_b64_tr_b16 v[74:75], v23 offset:1024
    ds_read_b128 v[84:87], v27 offset:0
    ds_read_b64_tr_b16 v[76:77], v23 offset:8192
    ds_read_b64_tr_b16 v[78:79], v23 offset:9216
    ds_read_b128 v[88:91], v27 offset:64
    s_waitcnt lgkmcnt(6)
    v_mfma_f32_16x16x32_bf16 v[96:99], v[80:83], v[92:95], 0
    s_waitcnt lgkmcnt(3)
    v_mfma_f32_16x16x32_bf16 v[96:99], v[72:75], v[84:87], v[96:99]
    s_waitcnt lgkmcnt(0)
    v_mfma_f32_16x16x32_bf16 v[96:99], v[76:79], v[88:91], v[96:99]
    s_mov_b32 exec_lo, 0x00010001
    s_mov_b32 exec_hi, 0x00010001
    s_nop 5
    v_and_or_b32 v96, v96, s45, v19
    v_and_or_b32 v97, v97, s45, v19
    v_and_or_b32 v98, v98, s45, v19
    v_and_or_b32 v99, v99, s45, v19
    global_store_dwordx4 v39, v[96:99], s[38:39] sc1
    s_mov_b64 exec, -1
    s_cmp_lg_u32 s5, 0
    s_cbranch_scc1 L_end
    s_cmp_ge_u32 s2, 128
    s_cbranch_scc1 L_fin
    s_lshl_b32 s8, s2, 10
    s_add_u32 s8, s8, 131072
    v_add_u32 v32, s8, v3
    s_sleep 8
    global_load_dwordx4 v[52:55], v32, s[38:39] sc1
    s_lshl_b32 s8, s2, 2
    v_add_u32 v1, s8, v132
    v_lshlrev_b32 v1, 1, v1
    v_add_u32 v45, 123904, v1
    ds_read_u16 v72, v45
    s_waitcnt vmcnt(0)
L_poll_4:
    v_bitop3_b32 v43, v52, v53, s41 bitop3:0x7e
    v_bitop3_b32 v44, v54, v55, s41 bitop3:0x7e
    v_bitop3_b32 v43, v43, v44, s42 bitop3:0xa8
    v_cmp_ne_u32 vcc, 0, v43
    s_cbranch_vccz L_poll_4_ok
    s_add_u32 s52, s52, 1
    s_cmp_gt_u32 s52, 100000
    s_cbranch_scc1 L_poll_4_ok
    s_sleep 2
    s_mov_b64 exec, vcc
    global_load_dwordx4 v[52:55], v32, s[38:39] sc1
    s_mov_b64 exec, -1
    s_waitcnt vmcnt(0)
    s_branch L_poll_4
L_poll_4_ok:
    v_and_b32 v52, s45, v52
    v_and_b32 v53, s45, v53
    v_and_b32 v54, s45, v54
    v_and_b32 v55, s45, v55
    s_nop 0
    v_permlane32_swap_b32 v52, v53
    v_permlane32_swap_b32 v54, v55
    v_add_f32 v52, v52, v53
    v_add_f32 v54, v54, v55
    s_nop 1
    v_permlane16_swap_b32 v52, v54
    v_add_f32 v52, v52, v54
    s_nop 1
    v_add_f32_dpp v52, v52, v52 row_ror:8 row_mask:0xf bank_mask:0xf
    s_nop 1
    v_add_f32_dpp v52, v52, v52 row_ror:4 row_mask:0xf bank_mask:0xf
    s_nop 1
    v_add_f32_dpp v52, v52, v52 row_ror:2 row_mask:0xf bank_mask:0xf
    s_nop 1
    v_add_f32_dpp v52, v52, v52 row_ror:1 row_mask:0xf bank_mask:0xf
    s_waitcnt lgkmcnt(0)
    v_lshlrev_b32 v72, 16, v72
    v_add_f32 v52, v52, v72
    v_cvt_pk_bf16_f32 v52, v52, v52
    s_mov_b32 exec_lo, 0x00010001
    s_mov_b32 exec_hi, 0x00010001
    global_store_short v1, v52, s[34:35]
    s_mov_b64 exec, -1
    s_cmp_lg_u32 s2, 0
    s_cbranch_scc1 L_fin
    v_mov_b32 v43, 0
    v_mov_b32 v44, s40
    s_mov_b64 exec, 1
    global_store_dword v43, v44, s[38:39] sc1
    s_mov_b64 exec, -1
L_fin:
L_end:
    s_endpgm
.section .rodata,"a"
.p2align 6
.amdhsa_kernel parallel_sum__sliding_block_cached__glu_gated_geglu__decode_kernel
  .amdhsa_next_free_vgpr 136
  .amdhsa_next_free_sgpr 100
  .amdhsa_accum_offset 136
  .amdhsa_group_segment_fixed_size 0
  .amdhsa_kernarg_size 96
  .amdhsa_user_sgpr_count 2
  .amdhsa_user_sgpr_kernarg_segment_ptr 1
  .amdhsa_system_sgpr_workgroup_id_x 1
  .amdhsa_float_denorm_mode_32 3
.end_amdhsa_kernel
```
